```python
import torch

def _softmax(x, axis=-1):
    return torch.softmax(x, dim=axis)
def _gelu(x):
    return torch.nn.functional.gelu(x, approximate="tanh")
def _silu(x):
    return torch.nn.functional.silu(x)
def _sigmoid(x):
    return torch.sigmoid(x)
def _layernorm(x, axis=-1, eps=1e-5):
    m = x.mean(dim=axis, keepdim=True)
    v = x.var(dim=axis, keepdim=True, unbiased=False)
    return (x - m) / torch.sqrt(v + eps)
def _scatter_add(tgt, idx, src, axis=0):
    return tgt.clone().index_add_(axis, idx, src)
def _segment_sum(src, seg, n):
    out = torch.zeros((n,) + src.shape[1:], dtype=src.dtype)
    return out.index_add_(0, seg, src)
def _pad(x, pw):
    flat = tuple(v for pair in reversed(pw) for v in pair)
    return torch.nn.functional.pad(x, flat)

kernel_name = 'standalone__low_rank_proj_linformer__sampling'

def setup_inputs():

    _w = (lambda a: (lambda t: t.to(torch.bfloat16) if t.is_floating_point() else t)(torch.as_tensor(a)))
    B, H, Sq, Skv, Dh, R = 8, 32, 8, 2048, 128, 8
    return {
        "q": _w((lambda *s: torch.randn(*s, dtype=torch.bfloat16) * 0.8)(B, H, Sq, Dh)),
        "k": _w((lambda *s: torch.randn(*s, dtype=torch.bfloat16) * 0.8)(B, H, Skv, Dh)),
        "v": _w((lambda *s: torch.randn(*s, dtype=torch.bfloat16) * 0.05)(B, H, Skv, Dh)),
        "e_proj": _w((lambda *s: torch.randn(*s, dtype=torch.bfloat16) * 0.8)(R, Skv) * (Skv ** -0.5)),
        "f_proj": _w((lambda *s: torch.randn(*s, dtype=torch.bfloat16) * 0.05)(R, Skv) * (Skv ** -0.5)),
    }

def reference(q, k, v, e_proj, f_proj):
    B, H, Sq, Dh = q.shape
    kp = torch.einsum("rn,bhnd->bhrd", e_proj, k)
    vp = torch.einsum("rn,bhnd->bhrd", f_proj, v)
    scores = torch.einsum("bhqd,bhrd->bhqr", q, kp) * (Dh ** -0.5)
    p = _softmax(scores, axis=-1)
    o = torch.einsum("bhqr,bhrd->bhqd", p, vp)
    return o
```

```asm
; @launch grid=(256,1,1) block=(64,1,1) lds=0
.amdgcn_target "amdgcn-amd-amdhsa--gfx950"
.text
.globl standalone__low_rank_proj_linformer__sampling_kernel
.p2align 8
.type standalone__low_rank_proj_linformer__sampling_kernel,@function
standalone__low_rank_proj_linformer__sampling_kernel:
    s_load_dwordx8 s[4:11], s[0:1], 0
    s_load_dwordx4 s[12:15], s[0:1], 32
    s_cmp_ge_u32 s2, 256
    s_cbranch_scc1 L_end
    s_and_b32 s37, s2, 0x6
    s_lshl_b32 s37, s37, 2
    s_and_b32 s38, s2, 0x18
    s_lshr_b32 s38, s38, 2
    s_or_b32 s37, s37, s38
    s_and_b32 s38, s2, 0xe1
    s_or_b32 s2, s37, s38
    v_and_b32 v3, 15, v0
    v_bfe_u32 v5, v0, 4, 2
    v_lshlrev_b32 v1, 4, v3
    v_lshlrev_b32 v2, 12, v3
    v_lshl_add_u32 v1, v5, 12, v1
    v_lshl_add_u32 v2, v5, 5, v2
    s_and_b32 s37, s2, 3
    s_lshl_b32 s37, s37, 17
    s_bfe_u32 s38, s2, 0x10002
    s_lshl_b32 s38, s38, 11
    s_or_b32 s44, s37, s38
    s_mov_b32 s32, s44
    s_lshr_b32 s33, s44, 7
    s_mov_b32 s45, 0
    s_lshl_b32 s37, s2, 19
    s_lshl_b32 s38, s2, 11
    s_mov_b32 s18, 0x80000
    s_mov_b32 s19, 0x20000
    s_waitcnt lgkmcnt(0)
    s_add_u32 s16, s6, s37
    s_addc_u32 s17, s7, 0
    buffer_load_dwordx4 v[80:83], v1, s[16:19], s32 offen offset:0 nt
    buffer_load_dwordx4 v[84:87], v1, s[16:19], s32 offen offset:256 nt
    buffer_load_dwordx4 v[88:91], v1, s[16:19], s32 offen offset:512 nt
    buffer_load_dwordx4 v[92:95], v1, s[16:19], s32 offen offset:768 nt
    s_mov_b64 s[20:21], s[10:11]
    s_mov_b32 s22, 0x8000
    s_mov_b32 s23, 0x20000
    buffer_load_dwordx4 v[96:99], v1, s[16:19], s32 offen offset:1024 nt
    buffer_load_dwordx4 v[100:103], v1, s[16:19], s32 offen offset:1280 nt
    buffer_load_dwordx4 v[104:107], v1, s[16:19], s32 offen offset:1536 nt
    buffer_load_dwordx4 v[108:111], v1, s[16:19], s32 offen offset:1792 nt
    buffer_load_dwordx4 a[16:19], v2, s[20:23], s33 offen
    s_add_u32 s45, s45, 0x4000
    s_and_b32 s32, s45, 0xffff8000
    s_add_u32 s32, s32, s44
    s_and_b32 s32, s32, 0x7ffff
    s_lshr_b32 s46, s45, 5
    s_and_b32 s46, s46, 0x4000
    s_or_b32 s32, s32, s46
    s_lshr_b32 s46, s45, 3
    s_and_b32 s46, s46, 0x800
    s_xor_b32 s32, s32, s46
    s_lshr_b32 s33, s32, 7
    buffer_load_dwordx4 v[112:115], v1, s[16:19], s32 offen offset:0 nt
    buffer_load_dwordx4 v[116:119], v1, s[16:19], s32 offen offset:256 nt
    buffer_load_dwordx4 v[120:123], v1, s[16:19], s32 offen offset:512 nt
    buffer_load_dwordx4 v[124:127], v1, s[16:19], s32 offen offset:768 nt
    buffer_load_dwordx4 v[128:131], v1, s[16:19], s32 offen offset:1024 nt
    buffer_load_dwordx4 v[132:135], v1, s[16:19], s32 offen offset:1280 nt
    buffer_load_dwordx4 v[136:139], v1, s[16:19], s32 offen offset:1536 nt
    buffer_load_dwordx4 v[140:143], v1, s[16:19], s32 offen offset:1792 nt
    buffer_load_dwordx4 a[20:23], v2, s[20:23], s33 offen
    s_add_u32 s45, s45, 0x4000
    s_and_b32 s32, s45, 0xffff8000
    s_add_u32 s32, s32, s44
    s_and_b32 s32, s32, 0x7ffff
    s_lshr_b32 s46, s45, 5
    s_and_b32 s46, s46, 0x4000
    s_or_b32 s32, s32, s46
    s_lshr_b32 s46, s45, 3
    s_and_b32 s46, s46, 0x800
    s_xor_b32 s32, s32, s46
    s_lshr_b32 s33, s32, 7
    buffer_load_dwordx4 v[144:147], v1, s[16:19], s32 offen offset:0 nt
    buffer_load_dwordx4 v[148:151], v1, s[16:19], s32 offen offset:256 nt
    buffer_load_dwordx4 v[152:155], v1, s[16:19], s32 offen offset:512 nt
    buffer_load_dwordx4 v[156:159], v1, s[16:19], s32 offen offset:768 nt
    buffer_load_dwordx4 v[160:163], v1, s[16:19], s32 offen offset:1024 nt
    buffer_load_dwordx4 v[164:167], v1, s[16:19], s32 offen offset:1280 nt
    v_and_b32 v3, 7, v0
    v_lshlrev_b32 v4, 8, v3
    v_lshl_add_u32 v4, v5, 6, v4
    s_add_u32 s24, s4, s38
    s_addc_u32 s25, s5, 0
    s_mov_b32 s26, 0x800
    s_mov_b32 s27, 0x20000
    buffer_load_dwordx4 a[0:3], v4, s[24:27], 0 offen offset:0
    buffer_load_dwordx4 a[4:7], v4, s[24:27], 0 offen offset:16
    buffer_load_dwordx4 a[8:11], v4, s[24:27], 0 offen offset:32
    buffer_load_dwordx4 a[12:15], v4, s[24:27], 0 offen offset:48
    buffer_load_dwordx4 v[168:171], v1, s[16:19], s32 offen offset:1536 nt
    s_add_u32 s40, s8, s37
    s_addc_u32 s41, s9, 0
    s_add_u32 s28, s14, s38
    s_addc_u32 s29, s15, 0
    s_mov_b32 s30, 0
    s_mov_b32 s31, 0x20000
    s_mov_b32 s35, 0x05040100
    s_mov_b32 s36, 0x07060302
    s_mov_b32 s42, 0x3db504f3
    s_mov_b32 s43, 0x3fb8aa3b
    s_mov_b32 s34, 0
    v_lshlrev_b32 v40, 2, v5
    v_sub_u32 v40, v3, v40
    v_cmp_gt_u32 vcc, 4, v40
    v_lshlrev_b32 v40, 4, v40
    v_mov_b32 v7, 0
    v_mov_b32 v41, 0x3f80
    v_cndmask_b32 v6, v7, v41, vcc
    v_lshlrev_b64 v[6:7], v40, v[6:7]
    v_and_b32 v4, 15, v0
    v_lshlrev_b32 v4, 8, v4
    v_lshl_add_u32 v4, v5, 6, v4
    v_mov_b64 v[8:9], 0
    v_mov_b64 v[10:11], 0
    v_mov_b64 v[12:13], 0
    v_mov_b64 v[14:15], 0
    v_mov_b64 v[16:17], 0
    v_mov_b64 v[18:19], 0
    v_mov_b64 v[20:21], 0
    v_mov_b64 v[22:23], 0
    v_mov_b64 v[24:25], 0
    v_mov_b64 v[26:27], 0
    v_mov_b64 v[28:29], 0
    v_mov_b64 v[30:31], 0
    v_mov_b64 v[32:33], 0
    v_mov_b64 v[34:35], 0
    v_mov_b64 v[36:37], 0
    v_mov_b64 v[38:39], 0
    s_waitcnt vmcnt(24)
    buffer_load_dwordx4 v[172:175], v1, s[16:19], s32 offen offset:1792 nt
    s_waitcnt vmcnt(24)
    buffer_load_dwordx4 a[24:27], v2, s[20:23], s33 offen
    s_add_u32 s45, s45, 0x4000
    s_and_b32 s32, s45, 0xffff8000
    s_add_u32 s32, s32, s44
    s_and_b32 s32, s32, 0x7ffff
    s_lshr_b32 s46, s45, 5
    s_and_b32 s46, s46, 0x4000
    s_or_b32 s32, s32, s46
    s_lshr_b32 s46, s45, 3
    s_and_b32 s46, s46, 0x800
    s_xor_b32 s32, s32, s46
    s_lshr_b32 s33, s32, 7
    s_waitcnt vmcnt(24)
    buffer_load_dwordx4 v[176:179], v1, s[16:19], s32 offen offset:0 nt
    s_waitcnt vmcnt(24)
    buffer_load_dwordx4 v[180:183], v1, s[16:19], s32 offen offset:256 nt
    s_waitcnt vmcnt(24)
    buffer_load_dwordx4 v[184:187], v1, s[16:19], s32 offen offset:512 nt
    s_waitcnt vmcnt(24)
    buffer_load_dwordx4 v[188:191], v1, s[16:19], s32 offen offset:768 nt
    s_waitcnt vmcnt(24)
    buffer_load_dwordx4 v[192:195], v1, s[16:19], s32 offen offset:1024 nt
    s_waitcnt vmcnt(24)
    buffer_load_dwordx4 v[196:199], v1, s[16:19], s32 offen offset:1280 nt
    s_waitcnt vmcnt(24)
    buffer_load_dwordx4 v[200:203], v1, s[16:19], s32 offen offset:1536 nt
L_loop:
    v_perm_b32 v40, v84, v80, s35
    v_perm_b32 v41, v92, v88, s35
    v_perm_b32 v42, v100, v96, s35
    v_perm_b32 v43, v108, v104, s35
    s_waitcnt vmcnt(24)
    buffer_load_dwordx4 v[204:207], v1, s[16:19], s32 offen offset:1792 nt
    v_perm_b32 v44, v84, v80, s36
    v_perm_b32 v45, v92, v88, s36
    v_perm_b32 v46, v100, v96, s36
    v_perm_b32 v47, v108, v104, s36
    v_mfma_f32_16x16x32_bf16 v[8:11], a[16:19], v[40:43], v[8:11]
    v_perm_b32 v40, v85, v81, s35
    v_perm_b32 v41, v93, v89, s35
    v_perm_b32 v42, v101, v97, s35
    v_perm_b32 v43, v109, v105, s35
    v_mfma_f32_16x16x32_bf16 v[12:15], a[16:19], v[44:47], v[12:15]
    s_waitcnt vmcnt(24)
    buffer_load_dwordx4 a[28:31], v2, s[20:23], s33 offen
    s_add_u32 s45, s45, 0x4000
    s_and_b32 s32, s45, 0xffff8000
    s_add_u32 s32, s32, s44
    s_and_b32 s32, s32, 0x7ffff
    s_lshr_b32 s46, s45, 5
    s_and_b32 s46, s46, 0x4000
    s_or_b32 s32, s32, s46
    s_lshr_b32 s46, s45, 3
    s_and_b32 s46, s46, 0x800
    s_xor_b32 s32, s32, s46
    s_lshr_b32 s33, s32, 7
    s_cmp_eq_u32 s34, 12
    s_cselect_b64 s[16:17], s[40:41], s[16:17]
    s_cselect_b64 s[20:21], s[12:13], s[20:21]
    v_perm_b32 v44, v85, v81, s36
    v_perm_b32 v45, v93, v89, s36
    v_perm_b32 v46, v101, v97, s36
    v_perm_b32 v47, v109, v105, s36
    v_mfma_f32_16x16x32_bf16 v[16:19], a[16:19], v[40:43], v[16:19]
    v_perm_b32 v40, v86, v82, s35
    v_perm_b32 v41, v94, v90, s35
    v_perm_b32 v42, v102, v98, s35
    v_perm_b32 v43, v110, v106, s35
    v_mfma_f32_16x16x32_bf16 v[20:23], a[16:19], v[44:47], v[20:23]
    s_waitcnt vmcnt(24)
    buffer_load_dwordx4 v[208:211], v1, s[16:19], s32 offen offset:0 nt
    v_perm_b32 v44, v86, v82, s36
    v_perm_b32 v45, v94, v90, s36
    v_perm_b32 v46, v102, v98, s36
    v_perm_b32 v47, v110, v106, s36
    v_mfma_f32_16x16x32_bf16 v[24:27], a[16:19], v[40:43], v[24:27]
    v_perm_b32 v40, v87, v83, s35
    v_perm_b32 v41, v95, v91, s35
    v_perm_b32 v42, v103, v99, s35
    v_perm_b32 v43, v111, v107, s35
    v_mfma_f32_16x16x32_bf16 v[28:31], a[16:19], v[44:47], v[28:31]
    s_waitcnt vmcnt(24)
    buffer_load_dwordx4 v[212:215], v1, s[16:19], s32 offen offset:256 nt
    v_perm_b32 v44, v87, v83, s36
    v_perm_b32 v45, v95, v91, s36
    v_perm_b32 v46, v103, v99, s36
    v_perm_b32 v47, v111, v107, s36
    v_mfma_f32_16x16x32_bf16 v[32:35], a[16:19], v[40:43], v[32:35]
    s_nop 0
    v_mfma_f32_16x16x32_bf16 v[36:39], a[16:19], v[44:47], v[36:39]
    s_waitcnt vmcnt(24)
    buffer_load_dwordx4 v[216:219], v1, s[16:19], s32 offen offset:512 nt
    s_waitcnt vmcnt(24)
    buffer_load_dwordx4 v[220:223], v1, s[16:19], s32 offen offset:768 nt
    s_waitcnt vmcnt(24)
    buffer_load_dwordx4 v[224:227], v1, s[16:19], s32 offen offset:1024 nt
    s_waitcnt vmcnt(24)
    buffer_load_dwordx4 v[228:231], v1, s[16:19], s32 offen offset:1280 nt
    s_waitcnt vmcnt(24)
    buffer_load_dwordx4 v[232:235], v1, s[16:19], s32 offen offset:1536 nt
    v_perm_b32 v40, v116, v112, s35
    v_perm_b32 v41, v124, v120, s35
    v_perm_b32 v42, v132, v128, s35
    v_perm_b32 v43, v140, v136, s35
    s_waitcnt vmcnt(24)
    buffer_load_dwordx4 v[236:239], v1, s[16:19], s32 offen offset:1792 nt
    v_perm_b32 v44, v116, v112, s36
    v_perm_b32 v45, v124, v120, s36
    v_perm_b32 v46, v132, v128, s36
    v_perm_b32 v47, v140, v136, s36
    v_mfma_f32_16x16x32_bf16 v[8:11], a[20:23], v[40:43], v[8:11]
    v_perm_b32 v40, v117, v113, s35
    v_perm_b32 v41, v125, v121, s35
    v_perm_b32 v42, v133, v129, s35
    v_perm_b32 v43, v141, v137, s35
    v_mfma_f32_16x16x32_bf16 v[12:15], a[20:23], v[44:47], v[12:15]
    s_waitcnt vmcnt(24)
    buffer_load_dwordx4 a[32:35], v2, s[20:23], s33 offen
    s_add_u32 s45, s45, 0x4000
    s_and_b32 s32, s45, 0xffff8000
    s_add_u32 s32, s32, s44
    s_and_b32 s32, s32, 0x7ffff
    s_lshr_b32 s46, s45, 5
    s_and_b32 s46, s46, 0x4000
    s_or_b32 s32, s32, s46
    s_lshr_b32 s46, s45, 3
    s_and_b32 s46, s46, 0x800
    s_xor_b32 s32, s32, s46
    s_lshr_b32 s33, s32, 7
    v_perm_b32 v44, v117, v113, s36
    v_perm_b32 v45, v125, v121, s36
    v_perm_b32 v46, v133, v129, s36
    v_perm_b32 v47, v141, v137, s36
    v_mfma_f32_16x16x32_bf16 v[16:19], a[20:23], v[40:43], v[16:19]
    v_perm_b32 v40, v118, v114, s35
    v_perm_b32 v41, v126, v122, s35
    v_perm_b32 v42, v134, v130, s35
    v_perm_b32 v43, v142, v138, s35
    v_mfma_f32_16x16x32_bf16 v[20:23], a[20:23], v[44:47], v[20:23]
    s_waitcnt vmcnt(24)
    buffer_load_dwordx4 v[80:83], v1, s[16:19], s32 offen offset:0 nt
    v_perm_b32 v44, v118, v114, s36
    v_perm_b32 v45, v126, v122, s36
    v_perm_b32 v46, v134, v130, s36
    v_perm_b32 v47, v142, v138, s36
    v_mfma_f32_16x16x32_bf16 v[24:27], a[20:23], v[40:43], v[24:27]
    v_perm_b32 v40, v119, v115, s35
    v_perm_b32 v41, v127, v123, s35
    v_perm_b32 v42, v135, v131, s35
    v_perm_b32 v43, v143, v139, s35
    v_mfma_f32_16x16x32_bf16 v[28:31], a[20:23], v[44:47], v[28:31]
    s_waitcnt vmcnt(24)
    buffer_load_dwordx4 v[84:87], v1, s[16:19], s32 offen offset:256 nt
    v_perm_b32 v44, v119, v115, s36
    v_perm_b32 v45, v127, v123, s36
    v_perm_b32 v46, v135, v131, s36
    v_perm_b32 v47, v143, v139, s36
    v_mfma_f32_16x16x32_bf16 v[32:35], a[20:23], v[40:43], v[32:35]
    s_nop 0
    v_mfma_f32_16x16x32_bf16 v[36:39], a[20:23], v[44:47], v[36:39]
    s_waitcnt vmcnt(24)
    buffer_load_dwordx4 v[88:91], v1, s[16:19], s32 offen offset:512 nt
    s_waitcnt vmcnt(24)
    buffer_load_dwordx4 v[92:95], v1, s[16:19], s32 offen offset:768 nt
    s_waitcnt vmcnt(24)
    buffer_load_dwordx4 v[96:99], v1, s[16:19], s32 offen offset:1024 nt
    s_waitcnt vmcnt(24)
    buffer_load_dwordx4 v[100:103], v1, s[16:19], s32 offen offset:1280 nt
    s_waitcnt vmcnt(24)
    buffer_load_dwordx4 v[104:107], v1, s[16:19], s32 offen offset:1536 nt
    v_perm_b32 v40, v148, v144, s35
    v_perm_b32 v41, v156, v152, s35
    v_perm_b32 v42, v164, v160, s35
    v_perm_b32 v43, v172, v168, s35
    s_waitcnt vmcnt(24)
    buffer_load_dwordx4 v[108:111], v1, s[16:19], s32 offen offset:1792 nt
    v_perm_b32 v44, v148, v144, s36
    v_perm_b32 v45, v156, v152, s36
    v_perm_b32 v46, v164, v160, s36
    v_perm_b32 v47, v172, v168, s36
    v_mfma_f32_16x16x32_bf16 v[8:11], a[24:27], v[40:43], v[8:11]
    v_perm_b32 v40, v149, v145, s35
    v_perm_b32 v41, v157, v153, s35
    v_perm_b32 v42, v165, v161, s35
    v_perm_b32 v43, v173, v169, s35
    v_mfma_f32_16x16x32_bf16 v[12:15], a[24:27], v[44:47], v[12:15]
    s_waitcnt vmcnt(24)
    buffer_load_dwordx4 a[16:19], v2, s[20:23], s33 offen
    s_add_u32 s45, s45, 0x4000
    s_and_b32 s32, s45, 0xffff8000
    s_add_u32 s32, s32, s44
    s_and_b32 s32, s32, 0x7ffff
    s_lshr_b32 s46, s45, 5
    s_and_b32 s46, s46, 0x4000
    s_or_b32 s32, s32, s46
    s_lshr_b32 s46, s45, 3
    s_and_b32 s46, s46, 0x800
    s_xor_b32 s32, s32, s46
    s_lshr_b32 s33, s32, 7
    v_perm_b32 v44, v149, v145, s36
    v_perm_b32 v45, v157, v153, s36
    v_perm_b32 v46, v165, v161, s36
    v_perm_b32 v47, v173, v169, s36
    v_mfma_f32_16x16x32_bf16 v[16:19], a[24:27], v[40:43], v[16:19]
    v_perm_b32 v40, v150, v146, s35
    v_perm_b32 v41, v158, v154, s35
    v_perm_b32 v42, v166, v162, s35
    v_perm_b32 v43, v174, v170, s35
    v_mfma_f32_16x16x32_bf16 v[20:23], a[24:27], v[44:47], v[20:23]
    s_waitcnt vmcnt(24)
    buffer_load_dwordx4 v[112:115], v1, s[16:19], s32 offen offset:0 nt
    v_perm_b32 v44, v150, v146, s36
    v_perm_b32 v45, v158, v154, s36
    v_perm_b32 v46, v166, v162, s36
    v_perm_b32 v47, v174, v170, s36
    v_mfma_f32_16x16x32_bf16 v[24:27], a[24:27], v[40:43], v[24:27]
    v_perm_b32 v40, v151, v147, s35
    v_perm_b32 v41, v159, v155, s35
    v_perm_b32 v42, v167, v163, s35
    v_perm_b32 v43, v175, v171, s35
    v_mfma_f32_16x16x32_bf16 v[28:31], a[24:27], v[44:47], v[28:31]
    s_waitcnt vmcnt(24)
    buffer_load_dwordx4 v[116:119], v1, s[16:19], s32 offen offset:256 nt
    v_perm_b32 v44, v151, v147, s36
    v_perm_b32 v45, v159, v155, s36
    v_perm_b32 v46, v167, v163, s36
    v_perm_b32 v47, v175, v171, s36
    v_mfma_f32_16x16x32_bf16 v[32:35], a[24:27], v[40:43], v[32:35]
    s_cmp_eq_u32 s34, 25
    v_mfma_f32_16x16x32_bf16 v[36:39], a[24:27], v[44:47], v[36:39]
    s_cbranch_scc1 L_phase
    s_waitcnt vmcnt(24)
    buffer_load_dwordx4 v[120:123], v1, s[16:19], s32 offen offset:512 nt
    s_waitcnt vmcnt(24)
    buffer_load_dwordx4 v[124:127], v1, s[16:19], s32 offen offset:768 nt
    s_waitcnt vmcnt(24)
    buffer_load_dwordx4 v[128:131], v1, s[16:19], s32 offen offset:1024 nt
    s_waitcnt vmcnt(24)
    buffer_load_dwordx4 v[132:135], v1, s[16:19], s32 offen offset:1280 nt
    s_waitcnt vmcnt(24)
    buffer_load_dwordx4 v[136:139], v1, s[16:19], s32 offen offset:1536 nt
    v_perm_b32 v40, v180, v176, s35
    v_perm_b32 v41, v188, v184, s35
    v_perm_b32 v42, v196, v192, s35
    v_perm_b32 v43, v204, v200, s35
    s_waitcnt vmcnt(24)
    buffer_load_dwordx4 v[140:143], v1, s[16:19], s32 offen offset:1792 nt
    v_perm_b32 v44, v180, v176, s36
    v_perm_b32 v45, v188, v184, s36
    v_perm_b32 v46, v196, v192, s36
    v_perm_b32 v47, v204, v200, s36
    v_mfma_f32_16x16x32_bf16 v[8:11], a[28:31], v[40:43], v[8:11]
    v_perm_b32 v40, v181, v177, s35
    v_perm_b32 v41, v189, v185, s35
    v_perm_b32 v42, v197, v193, s35
    v_perm_b32 v43, v205, v201, s35
    v_mfma_f32_16x16x32_bf16 v[12:15], a[28:31], v[44:47], v[12:15]
    s_waitcnt vmcnt(24)
    buffer_load_dwordx4 a[20:23], v2, s[20:23], s33 offen
    s_add_u32 s45, s45, 0x4000
    s_and_b32 s32, s45, 0xffff8000
    s_add_u32 s32, s32, s44
    s_and_b32 s32, s32, 0x7ffff
    s_lshr_b32 s46, s45, 5
    s_and_b32 s46, s46, 0x4000
    s_or_b32 s32, s32, s46
    s_lshr_b32 s46, s45, 3
    s_and_b32 s46, s46, 0x800
    s_xor_b32 s32, s32, s46
    s_lshr_b32 s33, s32, 7
    v_perm_b32 v44, v181, v177, s36
    v_perm_b32 v45, v189, v185, s36
    v_perm_b32 v46, v197, v193, s36
    v_perm_b32 v47, v205, v201, s36
    v_mfma_f32_16x16x32_bf16 v[16:19], a[28:31], v[40:43], v[16:19]
    v_perm_b32 v40, v182, v178, s35
    v_perm_b32 v41, v190, v186, s35
    v_perm_b32 v42, v198, v194, s35
    v_perm_b32 v43, v206, v202, s35
    v_mfma_f32_16x16x32_bf16 v[20:23], a[28:31], v[44:47], v[20:23]
    s_waitcnt vmcnt(24)
    buffer_load_dwordx4 v[144:147], v1, s[16:19], s32 offen offset:0 nt
    v_perm_b32 v44, v182, v178, s36
    v_perm_b32 v45, v190, v186, s36
    v_perm_b32 v46, v198, v194, s36
    v_perm_b32 v47, v206, v202, s36
    v_mfma_f32_16x16x32_bf16 v[24:27], a[28:31], v[40:43], v[24:27]
    v_perm_b32 v40, v183, v179, s35
    v_perm_b32 v41, v191, v187, s35
    v_perm_b32 v42, v199, v195, s35
    v_perm_b32 v43, v207, v203, s35
    v_mfma_f32_16x16x32_bf16 v[28:31], a[28:31], v[44:47], v[28:31]
    s_waitcnt vmcnt(24)
    buffer_load_dwordx4 v[148:151], v1, s[16:19], s32 offen offset:256 nt
    v_perm_b32 v44, v183, v179, s36
    v_perm_b32 v45, v191, v187, s36
    v_perm_b32 v46, v199, v195, s36
    v_perm_b32 v47, v207, v203, s36
    v_mfma_f32_16x16x32_bf16 v[32:35], a[28:31], v[40:43], v[32:35]
    s_cmp_eq_u32 s34, 12
    v_mfma_f32_16x16x32_bf16 v[36:39], a[28:31], v[44:47], v[36:39]
    s_cbranch_scc1 L_phaseK
    s_waitcnt vmcnt(24)
    buffer_load_dwordx4 v[152:155], v1, s[16:19], s32 offen offset:512 nt
    s_waitcnt vmcnt(24)
    buffer_load_dwordx4 v[156:159], v1, s[16:19], s32 offen offset:768 nt
    s_waitcnt vmcnt(24)
    buffer_load_dwordx4 v[160:163], v1, s[16:19], s32 offen offset:1024 nt
    s_waitcnt vmcnt(24)
    buffer_load_dwordx4 v[164:167], v1, s[16:19], s32 offen offset:1280 nt
    s_waitcnt vmcnt(24)
    buffer_load_dwordx4 v[168:171], v1, s[16:19], s32 offen offset:1536 nt
L_back:
    v_perm_b32 v40, v212, v208, s35
    v_perm_b32 v41, v220, v216, s35
    v_perm_b32 v42, v228, v224, s35
    v_perm_b32 v43, v236, v232, s35
    s_waitcnt vmcnt(24)
    buffer_load_dwordx4 v[172:175], v1, s[16:19], s32 offen offset:1792 nt
    v_perm_b32 v44, v212, v208, s36
    v_perm_b32 v45, v220, v216, s36
    v_perm_b32 v46, v228, v224, s36
    v_perm_b32 v47, v236, v232, s36
    v_mfma_f32_16x16x32_bf16 v[8:11], a[32:35], v[40:43], v[8:11]
    v_perm_b32 v40, v213, v209, s35
    v_perm_b32 v41, v221, v217, s35
    v_perm_b32 v42, v229, v225, s35
    v_perm_b32 v43, v237, v233, s35
    v_mfma_f32_16x16x32_bf16 v[12:15], a[32:35], v[44:47], v[12:15]
    s_waitcnt vmcnt(24)
    buffer_load_dwordx4 a[24:27], v2, s[20:23], s33 offen
    s_add_u32 s45, s45, 0x4000
    s_and_b32 s32, s45, 0xffff8000
    s_add_u32 s32, s32, s44
    s_and_b32 s32, s32, 0x7ffff
    s_lshr_b32 s46, s45, 5
    s_and_b32 s46, s46, 0x4000
    s_or_b32 s32, s32, s46
    s_lshr_b32 s46, s45, 3
    s_and_b32 s46, s46, 0x800
    s_xor_b32 s32, s32, s46
    s_lshr_b32 s33, s32, 7
    s_cmp_eq_u32 s34, 24
    s_cselect_b32 s18, 0, s18
    s_cselect_b32 s22, 0, s22
    v_perm_b32 v44, v213, v209, s36
    v_perm_b32 v45, v221, v217, s36
    v_perm_b32 v46, v229, v225, s36
    v_perm_b32 v47, v237, v233, s36
    v_mfma_f32_16x16x32_bf16 v[16:19], a[32:35], v[40:43], v[16:19]
    v_perm_b32 v40, v214, v210, s35
    v_perm_b32 v41, v222, v218, s35
    v_perm_b32 v42, v230, v226, s35
    v_perm_b32 v43, v238, v234, s35
    v_mfma_f32_16x16x32_bf16 v[20:23], a[32:35], v[44:47], v[20:23]
    s_waitcnt vmcnt(24)
    buffer_load_dwordx4 v[176:179], v1, s[16:19], s32 offen offset:0 nt
    v_perm_b32 v44, v214, v210, s36
    v_perm_b32 v45, v222, v218, s36
    v_perm_b32 v46, v230, v226, s36
    v_perm_b32 v47, v238, v234, s36
    v_mfma_f32_16x16x32_bf16 v[24:27], a[32:35], v[40:43], v[24:27]
    v_perm_b32 v40, v215, v211, s35
    v_perm_b32 v41, v223, v219, s35
    v_perm_b32 v42, v231, v227, s35
    v_perm_b32 v43, v239, v235, s35
    v_mfma_f32_16x16x32_bf16 v[28:31], a[32:35], v[44:47], v[28:31]
    s_waitcnt vmcnt(24)
    buffer_load_dwordx4 v[180:183], v1, s[16:19], s32 offen offset:256 nt
    v_perm_b32 v44, v215, v211, s36
    v_perm_b32 v45, v223, v219, s36
    v_perm_b32 v46, v231, v227, s36
    v_perm_b32 v47, v239, v235, s36
    v_mfma_f32_16x16x32_bf16 v[32:35], a[32:35], v[40:43], v[32:35]
    s_nop 0
    v_mfma_f32_16x16x32_bf16 v[36:39], a[32:35], v[44:47], v[36:39]
    s_waitcnt vmcnt(24)
    buffer_load_dwordx4 v[184:187], v1, s[16:19], s32 offen offset:512 nt
    s_waitcnt vmcnt(24)
    buffer_load_dwordx4 v[188:191], v1, s[16:19], s32 offen offset:768 nt
    s_waitcnt vmcnt(24)
    buffer_load_dwordx4 v[192:195], v1, s[16:19], s32 offen offset:1024 nt
    s_waitcnt vmcnt(24)
    buffer_load_dwordx4 v[196:199], v1, s[16:19], s32 offen offset:1280 nt
    s_waitcnt vmcnt(24)
    buffer_load_dwordx4 v[200:203], v1, s[16:19], s32 offen offset:1536 nt
    s_add_u32 s34, s34, 1
    s_branch L_loop
L_phaseK:
    buffer_load_dwordx4 v[152:155], v1, s[16:19], s32 offen offset:512 nt
    buffer_load_dwordx4 v[156:159], v1, s[16:19], s32 offen offset:768 nt
    buffer_load_dwordx4 v[160:163], v1, s[16:19], s32 offen offset:1024 nt
    buffer_load_dwordx4 v[164:167], v1, s[16:19], s32 offen offset:1280 nt
    buffer_load_dwordx4 v[168:171], v1, s[16:19], s32 offen offset:1536 nt
L_phase:
    v_cvt_pk_bf16_f32 v48, v8, v9
    v_cvt_pk_bf16_f32 v49, v10, v11
    v_cvt_pk_bf16_f32 v52, v12, v13
    v_cvt_pk_bf16_f32 v53, v14, v15
    v_mfma_f32_16x16x16_bf16 v[8:11], v[48:49], v[6:7], 0
    v_cvt_pk_bf16_f32 v56, v16, v17
    v_cvt_pk_bf16_f32 v57, v18, v19
    v_mfma_f32_16x16x16_bf16 v[12:15], v[52:53], v[6:7], 0
    v_cvt_pk_bf16_f32 v60, v20, v21
    v_cvt_pk_bf16_f32 v61, v22, v23
    v_mfma_f32_16x16x16_bf16 v[16:19], v[56:57], v[6:7], 0
    v_cvt_pk_bf16_f32 v64, v24, v25
    v_cvt_pk_bf16_f32 v65, v26, v27
    v_mfma_f32_16x16x16_bf16 v[20:23], v[60:61], v[6:7], 0
    v_cvt_pk_bf16_f32 v68, v28, v29
    v_cvt_pk_bf16_f32 v69, v30, v31
    v_mfma_f32_16x16x16_bf16 v[24:27], v[64:65], v[6:7], 0
    v_cvt_pk_bf16_f32 v72, v32, v33
    v_cvt_pk_bf16_f32 v73, v34, v35
    v_mfma_f32_16x16x16_bf16 v[28:31], v[68:69], v[6:7], 0
    v_cvt_pk_bf16_f32 v76, v36, v37
    v_cvt_pk_bf16_f32 v77, v38, v39
    v_mfma_f32_16x16x16_bf16 v[32:35], v[72:73], v[6:7], 0
    s_cmp_eq_u32 s34, 12
    v_mfma_f32_16x16x16_bf16 v[36:39], v[76:77], v[6:7], 0
    v_cvt_pk_bf16_f32 v48, v8, v12
    v_cvt_pk_bf16_f32 v52, v9, v13
    v_cvt_pk_bf16_f32 v56, v10, v14
    v_cvt_pk_bf16_f32 v60, v11, v15
    v_cvt_pk_bf16_f32 v49, v16, v20
    v_cvt_pk_bf16_f32 v53, v17, v21
    v_cvt_pk_bf16_f32 v57, v18, v22
    v_cvt_pk_bf16_f32 v61, v19, v23
    v_cvt_pk_bf16_f32 v50, v24, v28
    v_cvt_pk_bf16_f32 v54, v25, v29
    v_cvt_pk_bf16_f32 v58, v26, v30
    v_cvt_pk_bf16_f32 v62, v27, v31
    v_cvt_pk_bf16_f32 v51, v32, v36
    buffer_store_dwordx4 v[48:51], v4, s[28:31], 0 offen offset:0
    v_cvt_pk_bf16_f32 v55, v33, v37
    buffer_store_dwordx4 v[52:55], v4, s[28:31], 0 offen offset:16
    v_cvt_pk_bf16_f32 v59, v34, v38
    buffer_store_dwordx4 v[56:59], v4, s[28:31], 0 offen offset:32
    v_cvt_pk_bf16_f32 v63, v35, v39
    buffer_store_dwordx4 v[60:63], v4, s[28:31], 0 offen offset:48
    s_cbranch_scc0 L_end
    v_mfma_f32_16x16x32_bf16 v[64:67], v[48:51], a[0:3], 0
    v_mfma_f32_16x16x32_bf16 v[64:67], v[52:55], a[4:7], v[64:67]
    v_mfma_f32_16x16x32_bf16 v[64:67], v[56:59], a[8:11], v[64:67]
    v_mfma_f32_16x16x32_bf16 v[64:67], v[60:63], a[12:15], v[64:67]
    s_mov_b32 s30, 0x800
    v_cmp_gt_u32 vcc, 2, v5
    s_nop 5
    v_cvt_pk_bf16_f32 v68, v64, v65
    v_cvt_pk_bf16_f32 v69, v66, v67
    v_lshlrev_b32 v64, 16, v68
    v_and_b32 v65, 0xffff0000, v68
    v_lshlrev_b32 v66, 16, v69
    v_and_b32 v67, 0xffff0000, v69
    v_mul_f32 v64, s42, v64
    v_mul_f32 v65, s42, v65
    v_mul_f32 v66, s42, v66
    v_mul_f32 v67, s42, v67
    v_cvt_pk_bf16_f32 v68, v64, v65
    v_cvt_pk_bf16_f32 v69, v66, v67
    v_lshlrev_b32 v64, 16, v68
    v_and_b32 v65, 0xffff0000, v68
    v_lshlrev_b32 v66, 16, v69
    v_and_b32 v67, 0xffff0000, v69
    v_max3_f32 v68, v64, v65, v66
    v_max_f32 v68, v68, v67
    v_mov_b32 v69, v68
    s_nop 1
    v_permlane16_swap_b32 v68, v69
    s_nop 1
    v_max_f32 v68, v68, v69
    v_sub_f32 v64, v64, v68
    v_sub_f32 v65, v65, v68
    v_sub_f32 v66, v66, v68
    v_sub_f32 v67, v67, v68
    v_mul_f32 v64, s43, v64
    v_mul_f32 v65, s43, v65
    v_mul_f32 v66, s43, v66
    v_mul_f32 v67, s43, v67
    v_exp_f32 v64, v64
    v_exp_f32 v65, v65
    v_exp_f32 v66, v66
    v_exp_f32 v67, v67
    s_nop 0
    v_add_f32 v68, v64, v65
    v_add_f32 v69, v66, v67
    v_add_f32 v68, v68, v69
    v_mov_b32 v69, v68
    s_nop 1
    v_permlane16_swap_b32 v68, v69
    s_nop 1
    v_add_f32 v68, v68, v69
    v_rcp_f32 v68, v68
    s_nop 0
    v_mul_f32 v64, v64, v68
    v_mul_f32 v65, v65, v68
    v_mul_f32 v66, v66, v68
    v_mul_f32 v67, v67, v68
    v_cvt_pk_bf16_f32 v68, v64, v65
    v_cvt_pk_bf16_f32 v69, v66, v67
    v_cndmask_b32 v6, 0, v68, vcc
    v_cndmask_b32 v7, 0, v69, vcc
    v_mov_b64 v[8:9], 0
    v_mov_b64 v[10:11], 0
    v_mov_b64 v[12:13], 0
    v_mov_b64 v[14:15], 0
    v_mov_b64 v[16:17], 0
    v_mov_b64 v[18:19], 0
    v_mov_b64 v[20:21], 0
    v_mov_b64 v[22:23], 0
    v_mov_b64 v[24:25], 0
    v_mov_b64 v[26:27], 0
    v_mov_b64 v[28:29], 0
    v_mov_b64 v[30:31], 0
    v_mov_b64 v[32:33], 0
    v_mov_b64 v[34:35], 0
    v_mov_b64 v[36:37], 0
    v_mov_b64 v[38:39], 0
    s_waitcnt vmcnt(25)
    s_branch L_back
L_end:
    s_endpgm
.section .rodata,"a"
.p2align 6
.amdhsa_kernel standalone__low_rank_proj_linformer__sampling_kernel
  .amdhsa_next_free_vgpr 276
  .amdhsa_next_free_sgpr 48
  .amdhsa_accum_offset 240
  .amdhsa_group_segment_fixed_size 0
  .amdhsa_kernarg_size 64
  .amdhsa_user_sgpr_count 2
  .amdhsa_user_sgpr_kernarg_segment_ptr 1
  .amdhsa_system_sgpr_workgroup_id_x 1
  .amdhsa_float_denorm_mode_32 3
.end_amdhsa_kernel
```
